```python
import torch

def _softmax(x, axis=-1):
    return torch.softmax(x, dim=axis)
def _gelu(x):
    return torch.nn.functional.gelu(x, approximate="tanh")
def _silu(x):
    return torch.nn.functional.silu(x)
def _sigmoid(x):
    return torch.sigmoid(x)
def _layernorm(x, axis=-1, eps=1e-5):
    m = x.mean(dim=axis, keepdim=True)
    v = x.var(dim=axis, keepdim=True, unbiased=False)
    return (x - m) / torch.sqrt(v + eps)
def _scatter_add(tgt, idx, src, axis=0):
    return tgt.clone().index_add_(axis, idx, src)
def _segment_sum(src, seg, n):
    out = torch.zeros((n,) + src.shape[1:], dtype=src.dtype)
    return out.index_add_(0, seg, src)
def _pad(x, pw):
    flat = tuple(v for pair in reversed(pw) for v in pair)
    return torch.nn.functional.pad(x, flat)

kernel_name = 'standalone__batchnorm__sampling'

def setup_inputs():

    _w = (lambda a: (lambda t: t.to(torch.bfloat16) if t.is_floating_point() else t)(torch.as_tensor(a)))
    B, S, C = 1024, 1, 1024
    K = 3
    return {
        "x": _w((lambda *s: torch.randn(*s, dtype=torch.bfloat16) * 0.05)(B, S, C)),
        "w": _w((lambda *s: torch.randn(*s, dtype=torch.bfloat16) * 0.05)(K, C, C) * (1.0 / (K * C) ** 0.5)),
        "mean": _w((lambda *s: torch.randn(*s, dtype=torch.bfloat16) * 0.05)(C) * 0.1),
        "var": _w(torch.abs((lambda *s: torch.randn(*s, dtype=torch.bfloat16) * 0.05)(C)) + 0.5),
        "g": _w((lambda *s: torch.randn(*s, dtype=torch.bfloat16) * 0.05)(C) + 1.0),
        "b": _w((lambda *s: torch.randn(*s, dtype=torch.bfloat16) * 0.05)(C) * 0.1),
    }

def reference(x, w, mean, var, g, b):
    K = 3
    P = K // 2
    S = x.shape[1]
    xp = _pad(x, ((0, 0), (P, P), (0, 0)))
    y = sum(torch.einsum('bsc,cd->bsd', xp[:, k:k + S, :], w[k]) for k in range(K))
    inv_std = 1.0 / torch.sqrt(var + 1e-5)
    y = (y - mean) * (g * inv_std) + b
    return _silu(y)
```

```asm
; @launch grid=(256,1,1) block=(320,1,1) lds=131584
.amdgcn_target "amdgcn-amd-amdhsa--gfx950"
.text
.globl standalone__batchnorm__sampling_kernel
.p2align 8
.type standalone__batchnorm__sampling_kernel,@function
standalone__batchnorm__sampling_kernel:
  s_load_dwordx16 s[4:19], s[0:1], 0
  v_lshrrev_b32 v2, 6, v0
  s_cmpk_ge_u32 s2, 256
  s_cbranch_scc1 L_exit
  v_readfirstlane_b32 s38, v2
  s_lshr_b32 s28, s2, 6
  s_bfe_u32 s29, s2, 0x30003
  s_bfe_u32 s32, s2, 0x20001
  s_and_b32 s33, s2, 1
  s_lshl2_add_u32 s34, s32, s28
  s_lshl3_add_u32 s35, s33, s29
  s_lshl_b32 s37, s35, 7
  s_cmp_eq_u32 s38, 0
  s_cbranch_scc1 L_loader
  s_cmp_lg_u32 s38, 1
  s_cbranch_scc1 L_cons
  v_and_b32 v9, 63, v0
  v_lshl_add_u32 v9, v9, 1, s37
  s_waitcnt lgkmcnt(0)
  global_load_ushort v36, v9, s[8:9]
  global_load_ushort v37, v9, s[10:11]
  global_load_ushort v38, v9, s[12:13]
  global_load_ushort v39, v9, s[14:15]
  s_branch L_cons
L_exit:
  s_endpgm

L_loader:
  s_cmp_gt_u32 s29, 3
  s_subb_u32 s45, s29, 0
  s_lshl1_add_u32 s45, s45, s33
  s_add_u32 s45, s45, s32
  s_mul_i32 s41, s28, 7
  s_add_u32 s41, s41, 1
  s_lshr_b32 s41, s41, 1
  s_add_u32 s45, s45, s41
  s_cmp_ge_u32 s45, 14
  s_cselect_b32 s41, 12, -2
  s_sub_u32 s45, s45, s41
  s_cmp_eq_u32 s29, 3
  s_cselect_b32 s45, 1, s45
  s_lshl_b32 s45, s45, 2
  v_lshrrev_b32 v3, 3, v0
  v_lshlrev_b32 v3, 11, v3
  v_and_b32 v5, 7, v0
  v_lshrrev_b32 v6, 4, v0
  v_xor_b32 v7, v5, v6
  s_lshl_b32 s36, s34, 17
  v_lshl_add_u32 v10, v7, 4, v3
  v_add_u32 v10, s36, v10
  v_xor_b32 v11, 64, v10
  s_movk_i32 s50, 15360
  s_movk_i32 s51, 30720
  s_lshl_b32 s52, 1, 16
  v_add_u32 v11, s50, v11
  v_add_u32 v12, s51, v10
  v_add_u32 v13, s51, v11
  v_add_u32 v14, s52, v10
  v_add_u32 v15, s52, v11
  v_add_u32 v16, s52, v12
  v_add_u32 v17, s52, v13
  v_lshlrev_b32 v6, 2, v6
  v_and_b32 v6, 4, v6
  v_xor_b32 v7, v5, v6
  s_bitset1_b32 s37, 21
  v_lshl_add_u32 v18, v7, 4, v3
  v_add_u32 v18, s37, v18
  v_xor_b32 v19, 16, v18
  v_add_u32 v19, s50, v19
  v_add_u32 v20, s51, v18
  v_add_u32 v21, s51, v19
  v_add_u32 v22, s52, v18
  v_add_u32 v23, s52, v19
  v_add_u32 v24, s52, v20
  v_add_u32 v25, s52, v21
  s_lshl_b32 s22, 1, 21
  s_mov_b32 s23, 0x20000
  s_lshl_b32 s26, 1, 22
  s_mov_b32 s27, 0x20000
  s_mov_b32 s30, 0x87654210
  s_mov_b32 s31, 0xbfed3ca9
  s_mov_b32 s46, 0x23211110
  s_mov_b32 s47, 0x16882687
  s_lshr_b64 s[48:49], s[30:31], s45
  s_and_b32 s44, s48, 15
  s_lshr_b64 s[46:47], s[46:47], s45
  s_and_b32 s3, s46, 15
  s_cmp_eq_u32 s3, 1
  s_cselect_b32 s40, s44, 1
  s_mov_b32 m0, 0
  s_waitcnt lgkmcnt(0)
  s_mov_b64 s[20:21], s[4:5]
  buffer_load_dwordx4 v10, s[20:23], 0 offen offset:0 lds
  s_mov_b64 s[24:25], s[6:7]
  buffer_load_dwordx4 v11, s[20:23], 0 offen offset:1024 lds
  buffer_load_dwordx4 v12, s[20:23], 0 offen offset:2048 lds
  buffer_load_dwordx4 v13, s[20:23], 0 offen offset:3072 lds
  s_addk_i32 m0, 0x1000
  s_lshl_b32 s39, s3, 2
  buffer_load_dwordx4 v14, s[20:23], 0 offen offset:0 lds
  buffer_load_dwordx4 v15, s[20:23], 0 offen offset:1024 lds
  buffer_load_dwordx4 v16, s[20:23], 0 offen offset:2048 lds
  buffer_load_dwordx4 v17, s[20:23], 0 offen offset:3072 lds
  s_addk_i32 m0, 0x1000
  s_lshl_b32 s41, s40, 17
  buffer_load_dwordx4 v18, s[24:27], 0 offen offset:0 lds
  buffer_load_dwordx4 v19, s[24:27], 0 offen offset:1024 lds
  buffer_load_dwordx4 v20, s[24:27], 0 offen offset:2048 lds
  buffer_load_dwordx4 v21, s[24:27], 0 offen offset:3072 lds
  s_addk_i32 m0, 0x1000
  s_lshl_b32 s40, s40, 7
  buffer_load_dwordx4 v22, s[24:27], 0 offen offset:0 lds
  buffer_load_dwordx4 v23, s[24:27], 0 offen offset:1024 lds
  buffer_load_dwordx4 v24, s[24:27], 0 offen offset:2048 lds
  buffer_load_dwordx4 v25, s[24:27], 0 offen offset:3072 lds
  s_addk_i32 m0, 0x3000
  s_sub_u32 s52, s45, s39
  buffer_load_dwordx4 v18, s[24:27], s41 offen offset:0 lds
  buffer_load_dwordx4 v19, s[24:27], s41 offen offset:1024 lds
  buffer_load_dwordx4 v20, s[24:27], s41 offen offset:2048 lds
  buffer_load_dwordx4 v21, s[24:27], s41 offen offset:3072 lds
  s_addk_i32 m0, 0xe000
  s_bfm_b64 s[46:47], s52, s39
  buffer_load_dwordx4 v10, s[20:23], s40 offen offset:0 lds
  buffer_load_dwordx4 v11, s[20:23], s40 offen offset:1024 lds
  buffer_load_dwordx4 v12, s[20:23], s40 offen offset:2048 lds
  buffer_load_dwordx4 v13, s[20:23], s40 offen offset:3072 lds
  s_addk_i32 m0, 0x3000
  s_and_b64 s[46:47], s[46:47], s[30:31]
  buffer_load_dwordx4 v22, s[24:27], s41 offen offset:0 lds
  buffer_load_dwordx4 v23, s[24:27], s41 offen offset:1024 lds
  buffer_load_dwordx4 v24, s[24:27], s41 offen offset:2048 lds
  buffer_load_dwordx4 v25, s[24:27], s41 offen offset:3072 lds
  s_addk_i32 m0, 0xe000
  s_lshl_b64 s[46:47], s[46:47], 4
  buffer_load_dwordx4 v14, s[20:23], s40 offen offset:0 lds
  buffer_load_dwordx4 v15, s[20:23], s40 offen offset:1024 lds
  buffer_load_dwordx4 v16, s[20:23], s40 offen offset:2048 lds
  buffer_load_dwordx4 v17, s[20:23], s40 offen offset:3072 lds
  s_addk_i32 m0, 0x5000
  s_add_u32 s52, s52, 4
  s_bfm_b64 s[50:51], s52, s39
  s_andn2_b64 s[30:31], s[30:31], s[50:51]
  s_or_b64 s[30:31], s[30:31], s[46:47]
  s_and_b64 s[48:49], s[48:49], 15
  s_lshl_b64 s[48:49], s[48:49], s39
  s_or_b64 s[30:31], s[30:31], s[48:49]
  s_lshr_b64 s[30:31], s[30:31], 8
  s_cmp_eq_u32 s29, 3
  s_cselect_b32 s39, 0, s3
  s_and_b32 s45, s28, 1
  s_lshl1_add_u32 s44, s44, s45
  s_lshl_b32 s44, s44, 6
  s_add_u32 s44, s44, s33
  s_lshl_b32 s44, s44, 10
  s_add_u32 s44, s44, 0x200180
  v_and_b32 v33, 62, v0
  v_lshlrev_b32 v33, 10, v33
  s_and_b32 s42, s30, 15
  s_lshl_b32 s43, s42, 17
  s_lshl_b32 s42, s42, 7
  s_lshr_b64 s[30:31], s[30:31], 4
  s_cmp_lg_u32 s39, 1
  s_cbranch_scc1 L_nt1
  buffer_load_dword v34, v33, s[24:27], s44 offen
L_nt1:
  buffer_load_dwordx4 v18, s[24:27], s43 offen offset:0 lds
  buffer_load_dwordx4 v19, s[24:27], s43 offen offset:1024 lds
  buffer_load_dwordx4 v20, s[24:27], s43 offen offset:2048 lds
  buffer_load_dwordx4 v21, s[24:27], s43 offen offset:3072 lds
  s_addk_i32 m0, 0xe000
  s_and_b32 s40, s30, 15
  buffer_load_dwordx4 v10, s[20:23], s42 offen offset:0 lds
  buffer_load_dwordx4 v11, s[20:23], s42 offen offset:1024 lds
  buffer_load_dwordx4 v12, s[20:23], s42 offen offset:2048 lds
  buffer_load_dwordx4 v13, s[20:23], s42 offen offset:3072 lds
  s_addk_i32 m0, 0x3000
  s_lshl_b32 s41, s40, 17
  buffer_load_dwordx4 v22, s[24:27], s43 offen offset:0 lds
  buffer_load_dwordx4 v23, s[24:27], s43 offen offset:1024 lds
  buffer_load_dwordx4 v24, s[24:27], s43 offen offset:2048 lds
  buffer_load_dwordx4 v25, s[24:27], s43 offen offset:3072 lds
  s_addk_i32 m0, 0xe000
  s_lshl_b32 s40, s40, 7
  buffer_load_dwordx4 v14, s[20:23], s42 offen offset:0 lds
  buffer_load_dwordx4 v15, s[20:23], s42 offen offset:1024 lds
  buffer_load_dwordx4 v16, s[20:23], s42 offen offset:2048 lds
  buffer_load_dwordx4 v17, s[20:23], s42 offen offset:3072 lds
  s_addk_i32 m0, 0x5000
  s_lshr_b64 s[30:31], s[30:31], 4
  s_cmp_lg_u32 s39, 2
  s_cbranch_scc1 L_nt2
  buffer_load_dword v34, v33, s[24:27], s44 offen
L_nt2:
  buffer_load_dwordx4 v18, s[24:27], s41 offen offset:0 lds
  buffer_load_dwordx4 v19, s[24:27], s41 offen offset:1024 lds
  buffer_load_dwordx4 v20, s[24:27], s41 offen offset:2048 lds
  buffer_load_dwordx4 v21, s[24:27], s41 offen offset:3072 lds
  s_addk_i32 m0, 0xe000
  s_and_b32 s42, s30, 15
  buffer_load_dwordx4 v10, s[20:23], s40 offen offset:0 lds
  buffer_load_dwordx4 v11, s[20:23], s40 offen offset:1024 lds
  buffer_load_dwordx4 v12, s[20:23], s40 offen offset:2048 lds
  buffer_load_dwordx4 v13, s[20:23], s40 offen offset:3072 lds
  s_addk_i32 m0, 0x3000
  s_lshl_b32 s43, s42, 17
  s_waitcnt vmcnt(40)
  s_barrier
  buffer_load_dwordx4 v22, s[24:27], s41 offen offset:0 lds
  buffer_load_dwordx4 v23, s[24:27], s41 offen offset:1024 lds
  buffer_load_dwordx4 v24, s[24:27], s41 offen offset:2048 lds
  buffer_load_dwordx4 v25, s[24:27], s41 offen offset:3072 lds
  s_addk_i32 m0, 0xe000
  s_lshl_b32 s42, s42, 7
  buffer_load_dwordx4 v14, s[20:23], s40 offen offset:0 lds
  buffer_load_dwordx4 v15, s[20:23], s40 offen offset:1024 lds
  buffer_load_dwordx4 v16, s[20:23], s40 offen offset:2048 lds
  buffer_load_dwordx4 v17, s[20:23], s40 offen offset:3072 lds
  s_addk_i32 m0, 0x5000
  s_lshr_b64 s[30:31], s[30:31], 4
  s_cmp_lg_u32 s39, 3
  s_cbranch_scc1 L_nt3
  buffer_load_dword v34, v33, s[24:27], s44 offen
L_nt3:
  buffer_load_dwordx4 v18, s[24:27], s43 offen offset:0 lds
  buffer_load_dwordx4 v19, s[24:27], s43 offen offset:1024 lds
  buffer_load_dwordx4 v20, s[24:27], s43 offen offset:2048 lds
  buffer_load_dwordx4 v21, s[24:27], s43 offen offset:3072 lds
  s_addk_i32 m0, 0xe000
  s_and_b32 s40, s30, 15
  buffer_load_dwordx4 v10, s[20:23], s42 offen offset:0 lds
  buffer_load_dwordx4 v11, s[20:23], s42 offen offset:1024 lds
  buffer_load_dwordx4 v12, s[20:23], s42 offen offset:2048 lds
  buffer_load_dwordx4 v13, s[20:23], s42 offen offset:3072 lds
  s_addk_i32 m0, 0x3000
  s_lshl_b32 s41, s40, 17
  s_waitcnt vmcnt(40)
  s_barrier
  buffer_load_dwordx4 v22, s[24:27], s43 offen offset:0 lds
  buffer_load_dwordx4 v23, s[24:27], s43 offen offset:1024 lds
  buffer_load_dwordx4 v24, s[24:27], s43 offen offset:2048 lds
  buffer_load_dwordx4 v25, s[24:27], s43 offen offset:3072 lds
  s_addk_i32 m0, 0xe000
  s_lshl_b32 s40, s40, 7
  buffer_load_dwordx4 v14, s[20:23], s42 offen offset:0 lds
  buffer_load_dwordx4 v15, s[20:23], s42 offen offset:1024 lds
  buffer_load_dwordx4 v16, s[20:23], s42 offen offset:2048 lds
  buffer_load_dwordx4 v17, s[20:23], s42 offen offset:3072 lds
  s_addk_i32 m0, 0x5000
  s_lshr_b64 s[30:31], s[30:31], 4
  buffer_load_dwordx4 v18, s[24:27], s41 offen offset:0 lds
  buffer_load_dwordx4 v19, s[24:27], s41 offen offset:1024 lds
  buffer_load_dwordx4 v20, s[24:27], s41 offen offset:2048 lds
  buffer_load_dwordx4 v21, s[24:27], s41 offen offset:3072 lds
  s_addk_i32 m0, 0xe000
  s_and_b32 s42, s30, 15
  buffer_load_dwordx4 v10, s[20:23], s40 offen offset:0 lds
  buffer_load_dwordx4 v11, s[20:23], s40 offen offset:1024 lds
  buffer_load_dwordx4 v12, s[20:23], s40 offen offset:2048 lds
  buffer_load_dwordx4 v13, s[20:23], s40 offen offset:3072 lds
  s_addk_i32 m0, 0x3000
  s_lshl_b32 s43, s42, 17
  s_waitcnt vmcnt(40)
  s_barrier
  buffer_load_dwordx4 v22, s[24:27], s41 offen offset:0 lds
  buffer_load_dwordx4 v23, s[24:27], s41 offen offset:1024 lds
  buffer_load_dwordx4 v24, s[24:27], s41 offen offset:2048 lds
  buffer_load_dwordx4 v25, s[24:27], s41 offen offset:3072 lds
  s_addk_i32 m0, 0xe000
  s_lshl_b32 s42, s42, 7
  buffer_load_dwordx4 v14, s[20:23], s40 offen offset:0 lds
  buffer_load_dwordx4 v15, s[20:23], s40 offen offset:1024 lds
  buffer_load_dwordx4 v16, s[20:23], s40 offen offset:2048 lds
  buffer_load_dwordx4 v17, s[20:23], s40 offen offset:3072 lds
  s_addk_i32 m0, 0x5000
  s_lshr_b64 s[30:31], s[30:31], 4
  buffer_load_dwordx4 v18, s[24:27], s43 offen offset:0 lds
  buffer_load_dwordx4 v19, s[24:27], s43 offen offset:1024 lds
  buffer_load_dwordx4 v20, s[24:27], s43 offen offset:2048 lds
  buffer_load_dwordx4 v21, s[24:27], s43 offen offset:3072 lds
  s_addk_i32 m0, 0xe000
  s_and_b32 s40, s30, 15
  buffer_load_dwordx4 v10, s[20:23], s42 offen offset:0 lds
  buffer_load_dwordx4 v11, s[20:23], s42 offen offset:1024 lds
  buffer_load_dwordx4 v12, s[20:23], s42 offen offset:2048 lds
  buffer_load_dwordx4 v13, s[20:23], s42 offen offset:3072 lds
  s_addk_i32 m0, 0x3000
  s_lshl_b32 s41, s40, 17
  s_waitcnt vmcnt(40)
  s_barrier
  buffer_load_dwordx4 v22, s[24:27], s43 offen offset:0 lds
  buffer_load_dwordx4 v23, s[24:27], s43 offen offset:1024 lds
  buffer_load_dwordx4 v24, s[24:27], s43 offen offset:2048 lds
  buffer_load_dwordx4 v25, s[24:27], s43 offen offset:3072 lds
  s_addk_i32 m0, 0xe000
  s_lshl_b32 s40, s40, 7
  buffer_load_dwordx4 v14, s[20:23], s42 offen offset:0 lds
  buffer_load_dwordx4 v15, s[20:23], s42 offen offset:1024 lds
  buffer_load_dwordx4 v16, s[20:23], s42 offen offset:2048 lds
  buffer_load_dwordx4 v17, s[20:23], s42 offen offset:3072 lds
  s_addk_i32 m0, 0x5000
  s_lshr_b64 s[30:31], s[30:31], 4
  s_cmp_lg_u32 s39, 6
  s_cbranch_scc1 L_nt6
  buffer_load_dword v34, v33, s[24:27], s44 offen
L_nt6:
  buffer_load_dwordx4 v18, s[24:27], s41 offen offset:0 lds
  buffer_load_dwordx4 v19, s[24:27], s41 offen offset:1024 lds
  buffer_load_dwordx4 v20, s[24:27], s41 offen offset:2048 lds
  buffer_load_dwordx4 v21, s[24:27], s41 offen offset:3072 lds
  s_addk_i32 m0, 0xe000
  s_and_b32 s42, s30, 15
  buffer_load_dwordx4 v10, s[20:23], s40 offen offset:0 lds
  buffer_load_dwordx4 v11, s[20:23], s40 offen offset:1024 lds
  buffer_load_dwordx4 v12, s[20:23], s40 offen offset:2048 lds
  buffer_load_dwordx4 v13, s[20:23], s40 offen offset:3072 lds
  s_addk_i32 m0, 0x3000
  s_lshl_b32 s43, s42, 17
  s_waitcnt vmcnt(40)
  s_barrier
  buffer_load_dwordx4 v22, s[24:27], s41 offen offset:0 lds
  buffer_load_dwordx4 v23, s[24:27], s41 offen offset:1024 lds
  buffer_load_dwordx4 v24, s[24:27], s41 offen offset:2048 lds
  buffer_load_dwordx4 v25, s[24:27], s41 offen offset:3072 lds
  s_addk_i32 m0, 0xe000
  s_lshl_b32 s42, s42, 7
  buffer_load_dwordx4 v14, s[20:23], s40 offen offset:0 lds
  buffer_load_dwordx4 v15, s[20:23], s40 offen offset:1024 lds
  buffer_load_dwordx4 v16, s[20:23], s40 offen offset:2048 lds
  buffer_load_dwordx4 v17, s[20:23], s40 offen offset:3072 lds
  s_movk_i32 m0, 8192
  s_lshr_b64 s[30:31], s[30:31], 4
  s_cmp_lg_u32 s39, 7
  s_cbranch_scc1 L_nt7
  buffer_load_dword v34, v33, s[24:27], s44 offen
L_nt7:
  buffer_load_dwordx4 v18, s[24:27], s43 offen offset:0 lds
  buffer_load_dwordx4 v19, s[24:27], s43 offen offset:1024 lds
  buffer_load_dwordx4 v20, s[24:27], s43 offen offset:2048 lds
  buffer_load_dwordx4 v21, s[24:27], s43 offen offset:3072 lds
  s_addk_i32 m0, 0xe000
  s_and_b32 s40, s30, 15
  buffer_load_dwordx4 v10, s[20:23], s42 offen offset:0 lds
  buffer_load_dwordx4 v11, s[20:23], s42 offen offset:1024 lds
  buffer_load_dwordx4 v12, s[20:23], s42 offen offset:2048 lds
  buffer_load_dwordx4 v13, s[20:23], s42 offen offset:3072 lds
  s_addk_i32 m0, 0x3000
  s_lshl_b32 s41, s40, 17
  s_waitcnt vmcnt(40)
  s_barrier
  buffer_load_dwordx4 v22, s[24:27], s43 offen offset:0 lds
  buffer_load_dwordx4 v23, s[24:27], s43 offen offset:1024 lds
  buffer_load_dwordx4 v24, s[24:27], s43 offen offset:2048 lds
  buffer_load_dwordx4 v25, s[24:27], s43 offen offset:3072 lds
  s_addk_i32 m0, 0xe000
  s_lshl_b32 s40, s40, 7
  buffer_load_dwordx4 v14, s[20:23], s42 offen offset:0 lds
  buffer_load_dwordx4 v15, s[20:23], s42 offen offset:1024 lds
  buffer_load_dwordx4 v16, s[20:23], s42 offen offset:2048 lds
  buffer_load_dwordx4 v17, s[20:23], s42 offen offset:3072 lds
  s_addk_i32 m0, 0x5000
  s_lshr_b64 s[30:31], s[30:31], 4
  s_cmp_lg_u32 s39, 8
  s_cbranch_scc1 L_nt8
  buffer_load_dword v34, v33, s[24:27], s44 offen
L_nt8:
  buffer_load_dwordx4 v18, s[24:27], s41 offen offset:0 lds
  buffer_load_dwordx4 v19, s[24:27], s41 offen offset:1024 lds
  buffer_load_dwordx4 v20, s[24:27], s41 offen offset:2048 lds
  buffer_load_dwordx4 v21, s[24:27], s41 offen offset:3072 lds
  s_addk_i32 m0, 0xe000
  s_and_b32 s42, s30, 15
  buffer_load_dwordx4 v10, s[20:23], s40 offen offset:0 lds
  buffer_load_dwordx4 v11, s[20:23], s40 offen offset:1024 lds
  buffer_load_dwordx4 v12, s[20:23], s40 offen offset:2048 lds
  buffer_load_dwordx4 v13, s[20:23], s40 offen offset:3072 lds
  s_addk_i32 m0, 0x3000
  s_lshl_b32 s43, s42, 17
  s_waitcnt vmcnt(40)
  s_barrier
  buffer_load_dwordx4 v22, s[24:27], s41 offen offset:0 lds
  buffer_load_dwordx4 v23, s[24:27], s41 offen offset:1024 lds
  buffer_load_dwordx4 v24, s[24:27], s41 offen offset:2048 lds
  buffer_load_dwordx4 v25, s[24:27], s41 offen offset:3072 lds
  s_addk_i32 m0, 0xe000
  s_lshl_b32 s42, s42, 7
  buffer_load_dwordx4 v14, s[20:23], s40 offen offset:0 lds
  buffer_load_dwordx4 v15, s[20:23], s40 offen offset:1024 lds
  buffer_load_dwordx4 v16, s[20:23], s40 offen offset:2048 lds
  buffer_load_dwordx4 v17, s[20:23], s40 offen offset:3072 lds
  s_addk_i32 m0, 0x5000
  s_lshr_b64 s[30:31], s[30:31], 4
  buffer_load_dwordx4 v18, s[24:27], s43 offen offset:0 lds
  buffer_load_dwordx4 v19, s[24:27], s43 offen offset:1024 lds
  buffer_load_dwordx4 v20, s[24:27], s43 offen offset:2048 lds
  buffer_load_dwordx4 v21, s[24:27], s43 offen offset:3072 lds
  s_addk_i32 m0, 0xe000
  s_and_b32 s40, s30, 15
  buffer_load_dwordx4 v10, s[20:23], s42 offen offset:0 lds
  buffer_load_dwordx4 v11, s[20:23], s42 offen offset:1024 lds
  buffer_load_dwordx4 v12, s[20:23], s42 offen offset:2048 lds
  buffer_load_dwordx4 v13, s[20:23], s42 offen offset:3072 lds
  s_addk_i32 m0, 0x3000
  s_lshl_b32 s41, s40, 17
  s_waitcnt vmcnt(40)
  s_barrier
  buffer_load_dwordx4 v22, s[24:27], s43 offen offset:0 lds
  buffer_load_dwordx4 v23, s[24:27], s43 offen offset:1024 lds
  buffer_load_dwordx4 v24, s[24:27], s43 offen offset:2048 lds
  buffer_load_dwordx4 v25, s[24:27], s43 offen offset:3072 lds
  s_addk_i32 m0, 0xe000
  s_lshl_b32 s40, s40, 7
  buffer_load_dwordx4 v14, s[20:23], s42 offen offset:0 lds
  buffer_load_dwordx4 v15, s[20:23], s42 offen offset:1024 lds
  buffer_load_dwordx4 v16, s[20:23], s42 offen offset:2048 lds
  buffer_load_dwordx4 v17, s[20:23], s42 offen offset:3072 lds
  s_addk_i32 m0, 0x5000
  s_lshr_b64 s[30:31], s[30:31], 4
  buffer_load_dwordx4 v18, s[24:27], s41 offen offset:0 lds
  buffer_load_dwordx4 v19, s[24:27], s41 offen offset:1024 lds
  buffer_load_dwordx4 v20, s[24:27], s41 offen offset:2048 lds
  buffer_load_dwordx4 v21, s[24:27], s41 offen offset:3072 lds
  s_addk_i32 m0, 0xe000
  s_and_b32 s42, s30, 15
  buffer_load_dwordx4 v10, s[20:23], s40 offen offset:0 lds
  buffer_load_dwordx4 v11, s[20:23], s40 offen offset:1024 lds
  buffer_load_dwordx4 v12, s[20:23], s40 offen offset:2048 lds
  buffer_load_dwordx4 v13, s[20:23], s40 offen offset:3072 lds
  s_addk_i32 m0, 0x3000
  s_lshl_b32 s43, s42, 17
  s_waitcnt vmcnt(40)
  s_barrier
  buffer_load_dwordx4 v22, s[24:27], s41 offen offset:0 lds
  buffer_load_dwordx4 v23, s[24:27], s41 offen offset:1024 lds
  buffer_load_dwordx4 v24, s[24:27], s41 offen offset:2048 lds
  buffer_load_dwordx4 v25, s[24:27], s41 offen offset:3072 lds
  s_addk_i32 m0, 0xe000
  s_lshl_b32 s42, s42, 7
  buffer_load_dwordx4 v14, s[20:23], s40 offen offset:0 lds
  buffer_load_dwordx4 v15, s[20:23], s40 offen offset:1024 lds
  buffer_load_dwordx4 v16, s[20:23], s40 offen offset:2048 lds
  buffer_load_dwordx4 v17, s[20:23], s40 offen offset:3072 lds
  s_addk_i32 m0, 0x5000
  s_lshr_b64 s[30:31], s[30:31], 4
  buffer_load_dwordx4 v18, s[24:27], s43 offen offset:0 lds
  buffer_load_dwordx4 v19, s[24:27], s43 offen offset:1024 lds
  buffer_load_dwordx4 v20, s[24:27], s43 offen offset:2048 lds
  buffer_load_dwordx4 v21, s[24:27], s43 offen offset:3072 lds
  s_addk_i32 m0, 0xe000
  s_and_b32 s40, s30, 15
  buffer_load_dwordx4 v10, s[20:23], s42 offen offset:0 lds
  buffer_load_dwordx4 v11, s[20:23], s42 offen offset:1024 lds
  buffer_load_dwordx4 v12, s[20:23], s42 offen offset:2048 lds
  buffer_load_dwordx4 v13, s[20:23], s42 offen offset:3072 lds
  s_addk_i32 m0, 0x3000
  s_lshl_b32 s41, s40, 17
  s_waitcnt vmcnt(40)
  s_barrier
  buffer_load_dwordx4 v22, s[24:27], s43 offen offset:0 lds
  buffer_load_dwordx4 v23, s[24:27], s43 offen offset:1024 lds
  buffer_load_dwordx4 v24, s[24:27], s43 offen offset:2048 lds
  buffer_load_dwordx4 v25, s[24:27], s43 offen offset:3072 lds
  s_addk_i32 m0, 0xe000
  s_lshl_b32 s40, s40, 7
  buffer_load_dwordx4 v14, s[20:23], s42 offen offset:0 lds
  buffer_load_dwordx4 v15, s[20:23], s42 offen offset:1024 lds
  buffer_load_dwordx4 v16, s[20:23], s42 offen offset:2048 lds
  buffer_load_dwordx4 v17, s[20:23], s42 offen offset:3072 lds
  s_addk_i32 m0, 0x5000
  s_lshr_b64 s[30:31], s[30:31], 4
  buffer_load_dwordx4 v18, s[24:27], s41 offen offset:0 lds
  buffer_load_dwordx4 v19, s[24:27], s41 offen offset:1024 lds
  buffer_load_dwordx4 v20, s[24:27], s41 offen offset:2048 lds
  buffer_load_dwordx4 v21, s[24:27], s41 offen offset:3072 lds
  s_addk_i32 m0, 0xe000
  s_and_b32 s42, s30, 15
  buffer_load_dwordx4 v10, s[20:23], s40 offen offset:0 lds
  buffer_load_dwordx4 v11, s[20:23], s40 offen offset:1024 lds
  buffer_load_dwordx4 v12, s[20:23], s40 offen offset:2048 lds
  buffer_load_dwordx4 v13, s[20:23], s40 offen offset:3072 lds
  s_addk_i32 m0, 0x3000
  s_lshl_b32 s43, s42, 17
  s_waitcnt vmcnt(40)
  s_barrier
  buffer_load_dwordx4 v22, s[24:27], s41 offen offset:0 lds
  buffer_load_dwordx4 v23, s[24:27], s41 offen offset:1024 lds
  buffer_load_dwordx4 v24, s[24:27], s41 offen offset:2048 lds
  buffer_load_dwordx4 v25, s[24:27], s41 offen offset:3072 lds
  s_addk_i32 m0, 0xe000
  s_lshl_b32 s42, s42, 7
  buffer_load_dwordx4 v14, s[20:23], s40 offen offset:0 lds
  buffer_load_dwordx4 v15, s[20:23], s40 offen offset:1024 lds
  buffer_load_dwordx4 v16, s[20:23], s40 offen offset:2048 lds
  buffer_load_dwordx4 v17, s[20:23], s40 offen offset:3072 lds
  s_addk_i32 m0, 0x5000
  s_lshr_b64 s[30:31], s[30:31], 4
  buffer_load_dwordx4 v18, s[24:27], s43 offen offset:0 lds
  buffer_load_dwordx4 v19, s[24:27], s43 offen offset:1024 lds
  buffer_load_dwordx4 v20, s[24:27], s43 offen offset:2048 lds
  buffer_load_dwordx4 v21, s[24:27], s43 offen offset:3072 lds
  s_addk_i32 m0, 0xe000
  s_and_b32 s40, s30, 15
  buffer_load_dwordx4 v10, s[20:23], s42 offen offset:0 lds
  buffer_load_dwordx4 v11, s[20:23], s42 offen offset:1024 lds
  buffer_load_dwordx4 v12, s[20:23], s42 offen offset:2048 lds
  buffer_load_dwordx4 v13, s[20:23], s42 offen offset:3072 lds
  s_addk_i32 m0, 0x3000
  s_lshl_b32 s41, s40, 17
  s_waitcnt vmcnt(40)
  s_barrier
  buffer_load_dwordx4 v22, s[24:27], s43 offen offset:0 lds
  buffer_load_dwordx4 v23, s[24:27], s43 offen offset:1024 lds
  buffer_load_dwordx4 v24, s[24:27], s43 offen offset:2048 lds
  buffer_load_dwordx4 v25, s[24:27], s43 offen offset:3072 lds
  s_addk_i32 m0, 0xe000
  s_lshl_b32 s40, s40, 7
  buffer_load_dwordx4 v14, s[20:23], s42 offen offset:0 lds
  buffer_load_dwordx4 v15, s[20:23], s42 offen offset:1024 lds
  buffer_load_dwordx4 v16, s[20:23], s42 offen offset:2048 lds
  buffer_load_dwordx4 v17, s[20:23], s42 offen offset:3072 lds
  s_addk_i32 m0, 0x5000
  s_nop 0
  buffer_load_dwordx4 v18, s[24:27], s41 offen offset:0 lds
  buffer_load_dwordx4 v19, s[24:27], s41 offen offset:1024 lds
  buffer_load_dwordx4 v20, s[24:27], s41 offen offset:2048 lds
  buffer_load_dwordx4 v21, s[24:27], s41 offen offset:3072 lds
  s_addk_i32 m0, 0xe000
  s_nop 0
  buffer_load_dwordx4 v10, s[20:23], s40 offen offset:0 lds
  buffer_load_dwordx4 v11, s[20:23], s40 offen offset:1024 lds
  buffer_load_dwordx4 v12, s[20:23], s40 offen offset:2048 lds
  buffer_load_dwordx4 v13, s[20:23], s40 offen offset:3072 lds
  s_addk_i32 m0, 0x1000
  s_nop 0
  s_waitcnt vmcnt(40)
  s_barrier
  buffer_load_dwordx4 v14, s[20:23], s40 offen offset:0 lds
  buffer_load_dwordx4 v15, s[20:23], s40 offen offset:1024 lds
  buffer_load_dwordx4 v16, s[20:23], s40 offen offset:2048 lds
  buffer_load_dwordx4 v17, s[20:23], s40 offen offset:3072 lds
  s_addk_i32 m0, 0x2000
  s_nop 0
  buffer_load_dwordx4 v22, s[24:27], s41 offen offset:0 lds
  buffer_load_dwordx4 v23, s[24:27], s41 offen offset:1024 lds
  buffer_load_dwordx4 v24, s[24:27], s41 offen offset:2048 lds
  buffer_load_dwordx4 v25, s[24:27], s41 offen offset:3072 lds
  s_waitcnt vmcnt(32)
  s_barrier
  s_waitcnt vmcnt(16)
  s_barrier
  s_waitcnt vmcnt(4)
  s_barrier
  s_waitcnt vmcnt(0)
  s_barrier
  s_endpgm

.p2align 12
L_cons:
  s_sub_u32 s40, s38, 1
  s_lshr_b32 s41, s40, 1
  s_and_b32 s42, s40, 1
  s_lshl_b32 s44, s42, 11
  v_bfe_u32 v15, v0, 1, 3
  v_bfe_u32 v13, v0, 4, 2
  v_xor_b32 v15, v15, v13
  v_lshlrev_b32 v15, 4, v15
  v_and_b32 v12, 15, v0
  v_lshl_add_u32 v14, v12, 7, v15
  v_add_u32 v24, s44, v14
  v_xor_b32 v25, 64, v24
  v_bfe_u32 v15, v0, 2, 2
  v_lshlrev_b32 v14, 7, v15
  v_lshl_add_u32 v14, v13, 10, v14
  v_lshrrev_b32 v15, 1, v15
  v_xor_b32 v15, s41, v15
  v_lshl_add_u32 v14, v15, 6, v14
  v_bfe_u32 v15, v0, 4, 1
  v_and_b32 v11, 3, v0
  v_xor_b32 v15, v15, v11
  v_lshl_add_u32 v14, v15, 4, v14
  v_and_b32 v15, 1, v0
  v_lshl_add_u32 v14, v15, 3, v14
  v_add_u32 v26, 8192, v14
  v_xor_b32 v27, 8, v26
  v_add_u32 v28, 65536, v24
  v_add_u32 v29, 65536, v25
  v_add_u32 v30, 65536, v26
  v_add_u32 v31, 65536, v27
  s_lshl2_add_u32 s44, s34, s42
  s_lshl_b32 s44, s44, 15
  s_lshl1_add_u32 s45, s35, s41
  s_lshl_b32 s45, s45, 6
  s_add_u32 s44, s44, s45
  s_add_u32 s44, s44, 4096
  v_lshlrev_b32 v17, 13, v13
  v_and_b32 v10, 12, v0
  v_lshl_add_u32 v17, v10, 2, v17
  v_and_b32 v18, 2, v0
  v_lshl_add_u32 v17, v18, 1, v17
  v_and_b32 v18, 1, v0
  v_bfe_u32 v9, v0, 2, 1
  v_xor_b32 v20, v18, v9
  v_lshl_add_u32 v17, v20, 3, v17
  v_lshl_add_u32 v12, v10, 1, v11
  v_lshl_add_u32 v12, v9, 2, v12
  v_add_u32 v17, s44, v17
  v_add_u32 v19, 65536, v17
  v_mov_b32 v22, 0x05040100
  v_mov_b32 v23, 0x03020706
  v_cmp_ne_u32 vcc, 0, v18
  s_lshl_b32 s44, s41, 8
  s_add_u32 s44, s44, 131072
  v_cndmask_b32 v18, v22, v23, vcc
  v_lshl_add_u32 v21, v12, 3, s44
  v_xor_b32 v20, 32, v21
  s_mov_b32 s46, 0xbfb8aa3b
  s_mov_b32 s47, 0xbfb8aa3b
  s_waitcnt lgkmcnt(0)
  s_cmp_lg_u32 s38, 1
  s_cbranch_scc1 L_nopar
  v_and_b32 v9, 63, v0
  v_lshlrev_b32 v9, 3, v9
  v_add_u32 v9, 131072, v9
  s_waitcnt vmcnt(0)
  v_lshlrev_b32 v37, 16, v37
  v_add_f32 v37, 0x3727c5ac, v37
  v_cvt_pk_bf16_f32 v37, v37, v37
  v_lshlrev_b32 v37, 16, v37
  v_sqrt_f32 v37, v37
  v_lshlrev_b32 v36, 16, v36
  v_cvt_pk_bf16_f32 v37, v37, v37
  v_lshlrev_b32 v37, 16, v37
  v_rcp_f32 v37, v37
  v_lshlrev_b32 v38, 16, v38
  v_cvt_pk_bf16_f32 v37, v37, v37
  v_lshlrev_b32 v37, 16, v37
  v_mul_f32 v37, v37, v38
  v_cvt_pk_bf16_f32 v37, v37, v37
  v_lshlrev_b32 v37, 16, v37
  v_lshlrev_b32 v39, 16, v39
  v_fma_f32 v39, -v36, v37, v39
  v_mul_f32 v40, 0xbfb8aa3b, v37
  v_mul_f32 v41, 0xbfb8aa3b, v39
  ds_write_b64 v9, v[40:41]
L_nopar:
  s_barrier
  ds_read_b128 v[48:51], v24 offset:0
  ds_read_b64_tr_b16 v[64:65], v26 offset:0
  ds_read_b64_tr_b16 v[66:67], v26 offset:512
  ds_read_b128 v[52:55], v24 offset:4096
  ds_read_b64_tr_b16 v[68:69], v27 offset:0
  ds_read_b64_tr_b16 v[70:71], v27 offset:512
  ds_read_b128 v[56:59], v25 offset:0
  ds_read_b64_tr_b16 v[72:73], v26 offset:4096
  ds_read_b64_tr_b16 v[74:75], v26 offset:4608
  ds_read_b128 v[60:63], v25 offset:4096
  ds_read_b64_tr_b16 v[76:77], v27 offset:4096
  ds_read_b64_tr_b16 v[78:79], v27 offset:4608
  s_waitcnt lgkmcnt(6)
  v_mfma_f32_16x16x32_bf16 v[112:115], v[48:51], v[64:67], 0
  v_mfma_f32_16x16x32_bf16 v[116:119], v[48:51], v[68:71], 0
  v_mfma_f32_16x16x32_bf16 v[124:127], v[52:55], v[68:71], 0
  v_mfma_f32_16x16x32_bf16 v[120:123], v[52:55], v[64:67], 0
  s_barrier
  ds_read_b128 v[80:83], v24 offset:16384
  ds_read_b64_tr_b16 v[96:97], v26 offset:16384
  ds_read_b64_tr_b16 v[98:99], v26 offset:16896
  s_waitcnt lgkmcnt(3)
  v_mfma_f32_16x16x32_bf16 v[112:115], v[56:59], v[72:75], v[112:115]
  ds_read_b128 v[84:87], v24 offset:20480
  ds_read_b64_tr_b16 v[100:101], v27 offset:16384
  ds_read_b64_tr_b16 v[102:103], v27 offset:16896
  v_mfma_f32_16x16x32_bf16 v[116:119], v[56:59], v[76:79], v[116:119]
  ds_read_b128 v[88:91], v25 offset:16384
  ds_read_b64_tr_b16 v[104:105], v26 offset:20480
  ds_read_b64_tr_b16 v[106:107], v26 offset:20992
  v_mfma_f32_16x16x32_bf16 v[124:127], v[60:63], v[76:79], v[124:127]
  ds_read_b128 v[92:95], v25 offset:20480
  ds_read_b64_tr_b16 v[108:109], v27 offset:20480
  ds_read_b64_tr_b16 v[110:111], v27 offset:20992
  v_mfma_f32_16x16x32_bf16 v[120:123], v[60:63], v[72:75], v[120:123]
  s_waitcnt lgkmcnt(6)
  v_mfma_f32_16x16x32_bf16 v[112:115], v[80:83], v[96:99], v[112:115]
  v_mfma_f32_16x16x32_bf16 v[116:119], v[80:83], v[100:103], v[116:119]
  v_mfma_f32_16x16x32_bf16 v[124:127], v[84:87], v[100:103], v[124:127]
  v_mfma_f32_16x16x32_bf16 v[120:123], v[84:87], v[96:99], v[120:123]
  ds_read_b64 v[4:5], v21
  ds_read_b64 v[6:7], v20
  s_barrier
  ds_read_b128 v[48:51], v24 offset:32768
  ds_read_b64_tr_b16 v[64:65], v26 offset:32768
  ds_read_b64_tr_b16 v[66:67], v26 offset:33280
  s_waitcnt lgkmcnt(3)
  v_mfma_f32_16x16x32_bf16 v[112:115], v[88:91], v[104:107], v[112:115]
  ds_read_b128 v[52:55], v24 offset:36864
  ds_read_b64_tr_b16 v[68:69], v27 offset:32768
  ds_read_b64_tr_b16 v[70:71], v27 offset:33280
  v_mfma_f32_16x16x32_bf16 v[116:119], v[88:91], v[108:111], v[116:119]
  ds_read_b128 v[56:59], v25 offset:32768
  ds_read_b64_tr_b16 v[72:73], v26 offset:36864
  ds_read_b64_tr_b16 v[74:75], v26 offset:37376
  v_mfma_f32_16x16x32_bf16 v[124:127], v[92:95], v[108:111], v[124:127]
  ds_read_b128 v[60:63], v25 offset:36864
  ds_read_b64_tr_b16 v[76:77], v27 offset:36864
  ds_read_b64_tr_b16 v[78:79], v27 offset:37376
  v_mfma_f32_16x16x32_bf16 v[120:123], v[92:95], v[104:107], v[120:123]
  s_waitcnt lgkmcnt(6)
  v_mfma_f32_16x16x32_bf16 v[112:115], v[48:51], v[64:67], v[112:115]
  v_mfma_f32_16x16x32_bf16 v[116:119], v[48:51], v[68:71], v[116:119]
  v_mfma_f32_16x16x32_bf16 v[124:127], v[52:55], v[68:71], v[124:127]
  v_mfma_f32_16x16x32_bf16 v[120:123], v[52:55], v[64:67], v[120:123]
  s_barrier
  ds_read_b128 v[80:83], v24 offset:49152
  ds_read_b64_tr_b16 v[96:97], v26 offset:49152
  ds_read_b64_tr_b16 v[98:99], v26 offset:49664
  s_waitcnt lgkmcnt(3)
  v_mfma_f32_16x16x32_bf16 v[112:115], v[56:59], v[72:75], v[112:115]
  ds_read_b128 v[84:87], v24 offset:53248
  ds_read_b64_tr_b16 v[100:101], v27 offset:49152
  ds_read_b64_tr_b16 v[102:103], v27 offset:49664
  v_mfma_f32_16x16x32_bf16 v[116:119], v[56:59], v[76:79], v[116:119]
  ds_read_b128 v[88:91], v25 offset:49152
  ds_read_b64_tr_b16 v[104:105], v26 offset:53248
  ds_read_b64_tr_b16 v[106:107], v26 offset:53760
  v_mfma_f32_16x16x32_bf16 v[124:127], v[60:63], v[76:79], v[124:127]
  ds_read_b128 v[92:95], v25 offset:53248
  ds_read_b64_tr_b16 v[108:109], v27 offset:53248
  ds_read_b64_tr_b16 v[110:111], v27 offset:53760
  v_mfma_f32_16x16x32_bf16 v[120:123], v[60:63], v[72:75], v[120:123]
  s_waitcnt lgkmcnt(6)
  v_mfma_f32_16x16x32_bf16 v[112:115], v[80:83], v[96:99], v[112:115]
  v_mfma_f32_16x16x32_bf16 v[116:119], v[80:83], v[100:103], v[116:119]
  v_mfma_f32_16x16x32_bf16 v[124:127], v[84:87], v[100:103], v[124:127]
  v_mfma_f32_16x16x32_bf16 v[120:123], v[84:87], v[96:99], v[120:123]
  s_barrier
  ds_read_b128 v[48:51], v28 offset:0
  ds_read_b64_tr_b16 v[64:65], v30 offset:0
  ds_read_b64_tr_b16 v[66:67], v30 offset:512
  s_waitcnt lgkmcnt(3)
  v_mfma_f32_16x16x32_bf16 v[112:115], v[88:91], v[104:107], v[112:115]
  ds_read_b128 v[52:55], v28 offset:4096
  ds_read_b64_tr_b16 v[68:69], v31 offset:0
  ds_read_b64_tr_b16 v[70:71], v31 offset:512
  v_mfma_f32_16x16x32_bf16 v[116:119], v[88:91], v[108:111], v[116:119]
  ds_read_b128 v[56:59], v29 offset:0
  ds_read_b64_tr_b16 v[72:73], v30 offset:4096
  ds_read_b64_tr_b16 v[74:75], v30 offset:4608
  v_mfma_f32_16x16x32_bf16 v[124:127], v[92:95], v[108:111], v[124:127]
  ds_read_b128 v[60:63], v29 offset:4096
  ds_read_b64_tr_b16 v[76:77], v31 offset:4096
  ds_read_b64_tr_b16 v[78:79], v31 offset:4608
  v_mfma_f32_16x16x32_bf16 v[120:123], v[92:95], v[104:107], v[120:123]
  s_waitcnt lgkmcnt(6)
  v_mfma_f32_16x16x32_bf16 v[112:115], v[48:51], v[64:67], v[112:115]
  v_mfma_f32_16x16x32_bf16 v[116:119], v[48:51], v[68:71], v[116:119]
  v_mfma_f32_16x16x32_bf16 v[124:127], v[52:55], v[68:71], v[124:127]
  v_mfma_f32_16x16x32_bf16 v[120:123], v[52:55], v[64:67], v[120:123]
  s_barrier
  ds_read_b128 v[80:83], v28 offset:16384
  ds_read_b64_tr_b16 v[96:97], v30 offset:16384
  ds_read_b64_tr_b16 v[98:99], v30 offset:16896
  s_waitcnt lgkmcnt(3)
  v_mfma_f32_16x16x32_bf16 v[112:115], v[56:59], v[72:75], v[112:115]
  ds_read_b128 v[84:87], v28 offset:20480
  ds_read_b64_tr_b16 v[100:101], v31 offset:16384
  ds_read_b64_tr_b16 v[102:103], v31 offset:16896
  v_mfma_f32_16x16x32_bf16 v[116:119], v[56:59], v[76:79], v[116:119]
  ds_read_b128 v[88:91], v29 offset:16384
  ds_read_b64_tr_b16 v[104:105], v30 offset:20480
  ds_read_b64_tr_b16 v[106:107], v30 offset:20992
  v_mfma_f32_16x16x32_bf16 v[124:127], v[60:63], v[76:79], v[124:127]
  ds_read_b128 v[92:95], v29 offset:20480
  ds_read_b64_tr_b16 v[108:109], v31 offset:20480
  ds_read_b64_tr_b16 v[110:111], v31 offset:20992
  v_mfma_f32_16x16x32_bf16 v[120:123], v[60:63], v[72:75], v[120:123]
  s_waitcnt lgkmcnt(6)
  v_mfma_f32_16x16x32_bf16 v[112:115], v[80:83], v[96:99], v[112:115]
  v_mfma_f32_16x16x32_bf16 v[116:119], v[80:83], v[100:103], v[116:119]
  v_mfma_f32_16x16x32_bf16 v[124:127], v[84:87], v[100:103], v[124:127]
  v_mfma_f32_16x16x32_bf16 v[120:123], v[84:87], v[96:99], v[120:123]
  s_barrier
  ds_read_b128 v[48:51], v28 offset:32768
  ds_read_b64_tr_b16 v[64:65], v30 offset:32768
  ds_read_b64_tr_b16 v[66:67], v30 offset:33280
  s_waitcnt lgkmcnt(3)
  v_mfma_f32_16x16x32_bf16 v[112:115], v[88:91], v[104:107], v[112:115]
  ds_read_b128 v[52:55], v28 offset:36864
  ds_read_b64_tr_b16 v[68:69], v31 offset:32768
  ds_read_b64_tr_b16 v[70:71], v31 offset:33280
  v_mfma_f32_16x16x32_bf16 v[116:119], v[88:91], v[108:111], v[116:119]
  ds_read_b128 v[56:59], v29 offset:32768
  ds_read_b64_tr_b16 v[72:73], v30 offset:36864
  ds_read_b64_tr_b16 v[74:75], v30 offset:37376
  v_mfma_f32_16x16x32_bf16 v[124:127], v[92:95], v[108:111], v[124:127]
  ds_read_b128 v[60:63], v29 offset:36864
  ds_read_b64_tr_b16 v[76:77], v31 offset:36864
  ds_read_b64_tr_b16 v[78:79], v31 offset:37376
  v_mfma_f32_16x16x32_bf16 v[120:123], v[92:95], v[104:107], v[120:123]
  s_waitcnt lgkmcnt(6)
  v_mfma_f32_16x16x32_bf16 v[112:115], v[48:51], v[64:67], v[112:115]
  v_mfma_f32_16x16x32_bf16 v[116:119], v[48:51], v[68:71], v[116:119]
  v_mfma_f32_16x16x32_bf16 v[124:127], v[52:55], v[68:71], v[124:127]
  v_mfma_f32_16x16x32_bf16 v[120:123], v[52:55], v[64:67], v[120:123]
  s_barrier
  ds_read_b128 v[80:83], v28 offset:49152
  ds_read_b64_tr_b16 v[96:97], v30 offset:49152
  ds_read_b64_tr_b16 v[98:99], v30 offset:49664
  s_waitcnt lgkmcnt(3)
  v_mfma_f32_16x16x32_bf16 v[112:115], v[56:59], v[72:75], v[112:115]
  ds_read_b128 v[84:87], v28 offset:53248
  ds_read_b64_tr_b16 v[100:101], v31 offset:49152
  ds_read_b64_tr_b16 v[102:103], v31 offset:49664
  v_mfma_f32_16x16x32_bf16 v[116:119], v[56:59], v[76:79], v[116:119]
  ds_read_b128 v[88:91], v29 offset:49152
  ds_read_b64_tr_b16 v[104:105], v30 offset:53248
  ds_read_b64_tr_b16 v[106:107], v30 offset:53760
  v_mfma_f32_16x16x32_bf16 v[124:127], v[60:63], v[76:79], v[124:127]
  ds_read_b128 v[92:95], v29 offset:53248
  ds_read_b64_tr_b16 v[108:109], v31 offset:53248
  ds_read_b64_tr_b16 v[110:111], v31 offset:53760
  v_mfma_f32_16x16x32_bf16 v[120:123], v[60:63], v[72:75], v[120:123]
  s_waitcnt lgkmcnt(6)
  v_mfma_f32_16x16x32_bf16 v[112:115], v[80:83], v[96:99], v[112:115]
  v_mfma_f32_16x16x32_bf16 v[116:119], v[80:83], v[100:103], v[116:119]
  v_mfma_f32_16x16x32_bf16 v[124:127], v[84:87], v[100:103], v[124:127]
  v_mfma_f32_16x16x32_bf16 v[120:123], v[84:87], v[96:99], v[120:123]
  s_barrier
  ds_read_b128 v[48:51], v24 offset:0
  ds_read_b64_tr_b16 v[64:65], v26 offset:0
  ds_read_b64_tr_b16 v[66:67], v26 offset:512
  s_waitcnt lgkmcnt(3)
  v_mfma_f32_16x16x32_bf16 v[112:115], v[88:91], v[104:107], v[112:115]
  ds_read_b128 v[52:55], v24 offset:4096
  ds_read_b64_tr_b16 v[68:69], v27 offset:0
  ds_read_b64_tr_b16 v[70:71], v27 offset:512
  v_mfma_f32_16x16x32_bf16 v[116:119], v[88:91], v[108:111], v[116:119]
  ds_read_b128 v[56:59], v25 offset:0
  ds_read_b64_tr_b16 v[72:73], v26 offset:4096
  ds_read_b64_tr_b16 v[74:75], v26 offset:4608
  v_mfma_f32_16x16x32_bf16 v[124:127], v[92:95], v[108:111], v[124:127]
  ds_read_b128 v[60:63], v25 offset:4096
  ds_read_b64_tr_b16 v[76:77], v27 offset:4096
  ds_read_b64_tr_b16 v[78:79], v27 offset:4608
  v_mfma_f32_16x16x32_bf16 v[120:123], v[92:95], v[104:107], v[120:123]
  s_waitcnt lgkmcnt(6)
  v_mfma_f32_16x16x32_bf16 v[112:115], v[48:51], v[64:67], v[112:115]
  v_mfma_f32_16x16x32_bf16 v[116:119], v[48:51], v[68:71], v[116:119]
  v_mfma_f32_16x16x32_bf16 v[124:127], v[52:55], v[68:71], v[124:127]
  v_mfma_f32_16x16x32_bf16 v[120:123], v[52:55], v[64:67], v[120:123]
  s_barrier
  ds_read_b128 v[80:83], v24 offset:16384
  ds_read_b64_tr_b16 v[96:97], v26 offset:16384
  ds_read_b64_tr_b16 v[98:99], v26 offset:16896
  s_waitcnt lgkmcnt(3)
  v_mfma_f32_16x16x32_bf16 v[112:115], v[56:59], v[72:75], v[112:115]
  ds_read_b128 v[84:87], v24 offset:20480
  ds_read_b64_tr_b16 v[100:101], v27 offset:16384
  ds_read_b64_tr_b16 v[102:103], v27 offset:16896
  v_mfma_f32_16x16x32_bf16 v[116:119], v[56:59], v[76:79], v[116:119]
  ds_read_b128 v[88:91], v25 offset:16384
  ds_read_b64_tr_b16 v[104:105], v26 offset:20480
  ds_read_b64_tr_b16 v[106:107], v26 offset:20992
  v_mfma_f32_16x16x32_bf16 v[124:127], v[60:63], v[76:79], v[124:127]
  ds_read_b128 v[92:95], v25 offset:20480
  ds_read_b64_tr_b16 v[108:109], v27 offset:20480
  ds_read_b64_tr_b16 v[110:111], v27 offset:20992
  v_mfma_f32_16x16x32_bf16 v[120:123], v[60:63], v[72:75], v[120:123]
  s_waitcnt lgkmcnt(6)
  v_mfma_f32_16x16x32_bf16 v[112:115], v[80:83], v[96:99], v[112:115]
  v_mfma_f32_16x16x32_bf16 v[116:119], v[80:83], v[100:103], v[116:119]
  v_mfma_f32_16x16x32_bf16 v[124:127], v[84:87], v[100:103], v[124:127]
  v_mfma_f32_16x16x32_bf16 v[120:123], v[84:87], v[96:99], v[120:123]
  s_barrier
  ds_read_b128 v[48:51], v24 offset:32768
  ds_read_b64_tr_b16 v[64:65], v26 offset:32768
  ds_read_b64_tr_b16 v[66:67], v26 offset:33280
  s_waitcnt lgkmcnt(3)
  v_mfma_f32_16x16x32_bf16 v[112:115], v[88:91], v[104:107], v[112:115]
  ds_read_b128 v[52:55], v24 offset:36864
  ds_read_b64_tr_b16 v[68:69], v27 offset:32768
  ds_read_b64_tr_b16 v[70:71], v27 offset:33280
  v_mfma_f32_16x16x32_bf16 v[116:119], v[88:91], v[108:111], v[116:119]
  ds_read_b128 v[56:59], v25 offset:32768
  ds_read_b64_tr_b16 v[72:73], v26 offset:36864
  ds_read_b64_tr_b16 v[74:75], v26 offset:37376
  v_mfma_f32_16x16x32_bf16 v[124:127], v[92:95], v[108:111], v[124:127]
  ds_read_b128 v[60:63], v25 offset:36864
  ds_read_b64_tr_b16 v[76:77], v27 offset:36864
  ds_read_b64_tr_b16 v[78:79], v27 offset:37376
  v_mfma_f32_16x16x32_bf16 v[120:123], v[92:95], v[104:107], v[120:123]
  s_waitcnt lgkmcnt(6)
  v_mfma_f32_16x16x32_bf16 v[112:115], v[48:51], v[64:67], v[112:115]
  v_mfma_f32_16x16x32_bf16 v[116:119], v[48:51], v[68:71], v[116:119]
  v_mfma_f32_16x16x32_bf16 v[124:127], v[52:55], v[68:71], v[124:127]
  v_mfma_f32_16x16x32_bf16 v[120:123], v[52:55], v[64:67], v[120:123]
  s_barrier
  ds_read_b128 v[80:83], v24 offset:49152
  ds_read_b64_tr_b16 v[96:97], v26 offset:49152
  ds_read_b64_tr_b16 v[98:99], v26 offset:49664
  s_waitcnt lgkmcnt(3)
  v_mfma_f32_16x16x32_bf16 v[112:115], v[56:59], v[72:75], v[112:115]
  ds_read_b128 v[84:87], v24 offset:53248
  ds_read_b64_tr_b16 v[100:101], v27 offset:49152
  ds_read_b64_tr_b16 v[102:103], v27 offset:49664
  v_mfma_f32_16x16x32_bf16 v[116:119], v[56:59], v[76:79], v[116:119]
  ds_read_b128 v[88:91], v25 offset:49152
  ds_read_b64_tr_b16 v[104:105], v26 offset:53248
  ds_read_b64_tr_b16 v[106:107], v26 offset:53760
  v_mfma_f32_16x16x32_bf16 v[124:127], v[60:63], v[76:79], v[124:127]
  ds_read_b128 v[92:95], v25 offset:53248
  ds_read_b64_tr_b16 v[108:109], v27 offset:53248
  ds_read_b64_tr_b16 v[110:111], v27 offset:53760
  v_mfma_f32_16x16x32_bf16 v[120:123], v[60:63], v[72:75], v[120:123]
  s_waitcnt lgkmcnt(6)
  v_mfma_f32_16x16x32_bf16 v[112:115], v[80:83], v[96:99], v[112:115]
  v_mfma_f32_16x16x32_bf16 v[116:119], v[80:83], v[100:103], v[116:119]
  v_mfma_f32_16x16x32_bf16 v[124:127], v[84:87], v[100:103], v[124:127]
  v_mfma_f32_16x16x32_bf16 v[120:123], v[84:87], v[96:99], v[120:123]
  s_barrier
  ds_read_b128 v[48:51], v28 offset:0
  ds_read_b64_tr_b16 v[64:65], v30 offset:0
  ds_read_b64_tr_b16 v[66:67], v30 offset:512
  s_waitcnt lgkmcnt(3)
  v_mfma_f32_16x16x32_bf16 v[112:115], v[88:91], v[104:107], v[112:115]
  ds_read_b128 v[52:55], v28 offset:4096
  ds_read_b64_tr_b16 v[68:69], v31 offset:0
  ds_read_b64_tr_b16 v[70:71], v31 offset:512
  v_mfma_f32_16x16x32_bf16 v[116:119], v[88:91], v[108:111], v[116:119]
  ds_read_b128 v[56:59], v29 offset:0
  ds_read_b64_tr_b16 v[72:73], v30 offset:4096
  ds_read_b64_tr_b16 v[74:75], v30 offset:4608
  v_mfma_f32_16x16x32_bf16 v[124:127], v[92:95], v[108:111], v[124:127]
  ds_read_b128 v[60:63], v29 offset:4096
  ds_read_b64_tr_b16 v[76:77], v31 offset:4096
  ds_read_b64_tr_b16 v[78:79], v31 offset:4608
  v_mfma_f32_16x16x32_bf16 v[120:123], v[92:95], v[104:107], v[120:123]
  s_waitcnt lgkmcnt(6)
  v_mfma_f32_16x16x32_bf16 v[112:115], v[48:51], v[64:67], v[112:115]
  v_mfma_f32_16x16x32_bf16 v[116:119], v[48:51], v[68:71], v[116:119]
  v_mfma_f32_16x16x32_bf16 v[124:127], v[52:55], v[68:71], v[124:127]
  v_mfma_f32_16x16x32_bf16 v[120:123], v[52:55], v[64:67], v[120:123]
  s_barrier
  ds_read_b128 v[80:83], v28 offset:16384
  ds_read_b64_tr_b16 v[96:97], v30 offset:16384
  ds_read_b64_tr_b16 v[98:99], v30 offset:16896
  s_waitcnt lgkmcnt(3)
  v_mfma_f32_16x16x32_bf16 v[112:115], v[56:59], v[72:75], v[112:115]
  ds_read_b128 v[84:87], v28 offset:20480
  ds_read_b64_tr_b16 v[100:101], v31 offset:16384
  ds_read_b64_tr_b16 v[102:103], v31 offset:16896
  v_mfma_f32_16x16x32_bf16 v[116:119], v[56:59], v[76:79], v[116:119]
  ds_read_b128 v[88:91], v29 offset:16384
  ds_read_b64_tr_b16 v[104:105], v30 offset:20480
  ds_read_b64_tr_b16 v[106:107], v30 offset:20992
  v_mfma_f32_16x16x32_bf16 v[124:127], v[60:63], v[76:79], v[124:127]
  ds_read_b128 v[92:95], v29 offset:20480
  ds_read_b64_tr_b16 v[108:109], v31 offset:20480
  ds_read_b64_tr_b16 v[110:111], v31 offset:20992
  v_mfma_f32_16x16x32_bf16 v[120:123], v[60:63], v[72:75], v[120:123]
  s_waitcnt lgkmcnt(6)
  v_mfma_f32_16x16x32_bf16 v[112:115], v[80:83], v[96:99], v[112:115]
  v_mfma_f32_16x16x32_bf16 v[116:119], v[80:83], v[100:103], v[116:119]
  v_mfma_f32_16x16x32_bf16 v[124:127], v[84:87], v[100:103], v[124:127]
  v_mfma_f32_16x16x32_bf16 v[120:123], v[84:87], v[96:99], v[120:123]
  s_barrier
  ds_read_b128 v[48:51], v28 offset:32768
  ds_read_b64_tr_b16 v[64:65], v30 offset:32768
  ds_read_b64_tr_b16 v[66:67], v30 offset:33280
  s_waitcnt lgkmcnt(3)
  v_mfma_f32_16x16x32_bf16 v[112:115], v[88:91], v[104:107], v[112:115]
  ds_read_b128 v[52:55], v28 offset:36864
  ds_read_b64_tr_b16 v[68:69], v31 offset:32768
  ds_read_b64_tr_b16 v[70:71], v31 offset:33280
  v_mfma_f32_16x16x32_bf16 v[116:119], v[88:91], v[108:111], v[116:119]
  ds_read_b128 v[56:59], v29 offset:32768
  ds_read_b64_tr_b16 v[72:73], v30 offset:36864
  ds_read_b64_tr_b16 v[74:75], v30 offset:37376
  v_mfma_f32_16x16x32_bf16 v[124:127], v[92:95], v[108:111], v[124:127]
  ds_read_b128 v[60:63], v29 offset:36864
  ds_read_b64_tr_b16 v[76:77], v31 offset:36864
  ds_read_b64_tr_b16 v[78:79], v31 offset:37376
  v_mfma_f32_16x16x32_bf16 v[120:123], v[92:95], v[104:107], v[120:123]
  s_waitcnt lgkmcnt(6)
  v_mfma_f32_16x16x32_bf16 v[112:115], v[48:51], v[64:67], v[112:115]
  v_mfma_f32_16x16x32_bf16 v[116:119], v[48:51], v[68:71], v[116:119]
  v_mfma_f32_16x16x32_bf16 v[124:127], v[52:55], v[68:71], v[124:127]
  v_mfma_f32_16x16x32_bf16 v[120:123], v[52:55], v[64:67], v[120:123]
  s_barrier
  ds_read_b128 v[80:83], v28 offset:49152
  ds_read_b64_tr_b16 v[96:97], v30 offset:49152
  ds_read_b64_tr_b16 v[98:99], v30 offset:49664
  s_waitcnt lgkmcnt(3)
  v_mfma_f32_16x16x32_bf16 v[112:115], v[56:59], v[72:75], v[112:115]
  ds_read_b128 v[84:87], v28 offset:53248
  ds_read_b64_tr_b16 v[100:101], v31 offset:49152
  ds_read_b64_tr_b16 v[102:103], v31 offset:49664
  v_mfma_f32_16x16x32_bf16 v[116:119], v[56:59], v[76:79], v[116:119]
  ds_read_b128 v[88:91], v29 offset:49152
  ds_read_b128 v[92:95], v29 offset:53248
  v_mfma_f32_16x16x32_bf16 v[124:127], v[60:63], v[76:79], v[124:127]
  s_barrier
  ds_read_b64_tr_b16 v[104:105], v30 offset:53248
  ds_read_b64_tr_b16 v[106:107], v30 offset:53760
  ds_read_b64_tr_b16 v[108:109], v31 offset:53248
  ds_read_b64_tr_b16 v[110:111], v31 offset:53760
  v_mfma_f32_16x16x32_bf16 v[120:123], v[60:63], v[72:75], v[120:123]
  s_waitcnt lgkmcnt(6)
  v_mfma_f32_16x16x32_bf16 v[112:115], v[80:83], v[96:99], v[112:115]
  v_mfma_f32_16x16x32_bf16 v[116:119], v[80:83], v[100:103], v[116:119]
  s_waitcnt lgkmcnt(2)
  v_mfma_f32_16x16x32_bf16 v[112:115], v[88:91], v[104:107], v[112:115]
  s_waitcnt lgkmcnt(0)
  v_mfma_f32_16x16x32_bf16 v[116:119], v[88:91], v[108:111], v[116:119]
  v_mfma_f32_16x16x32_bf16 v[124:127], v[84:87], v[100:103], v[124:127]
  v_mfma_f32_16x16x32_bf16 v[120:123], v[84:87], v[96:99], v[120:123]
  v_mfma_f32_16x16x32_bf16 v[124:127], v[92:95], v[108:111], v[124:127]
  v_mfma_f32_16x16x32_bf16 v[120:123], v[92:95], v[104:107], v[120:123]
  s_nop 2
  v_pk_fma_f32 v[48:49], v[112:113], v[4:5], v[4:5] op_sel:[0,0,1] op_sel_hi:[1,0,1]
  v_pk_fma_f32 v[52:53], v[116:117], v[6:7], v[6:7] op_sel:[0,0,1] op_sel_hi:[1,0,1]
  v_exp_f32 v64, v48
  v_exp_f32 v65, v49
  v_exp_f32 v68, v52
  v_exp_f32 v69, v53
  v_pk_fma_f32 v[64:65], v[64:65], s[46:47], s[46:47]
  v_pk_fma_f32 v[68:69], v[68:69], s[46:47], s[46:47]
  v_rcp_f32 v64, v64
  v_rcp_f32 v65, v65
  v_rcp_f32 v68, v68
  v_rcp_f32 v69, v69
  v_pk_mul_f32 v[48:49], v[48:49], v[64:65]
  v_pk_mul_f32 v[52:53], v[52:53], v[68:69]
  v_cvt_pk_bf16_f32 v40, v48, v52
  v_cvt_pk_bf16_f32 v41, v49, v53
  v_pk_fma_f32 v[50:51], v[114:115], v[4:5], v[4:5] op_sel:[0,0,1] op_sel_hi:[1,0,1]
  v_pk_fma_f32 v[54:55], v[118:119], v[6:7], v[6:7] op_sel:[0,0,1] op_sel_hi:[1,0,1]
  v_mov_b32_dpp v22, v40 quad_perm:[1,0,3,2] row_mask:0xf bank_mask:0xf
  v_mov_b32_dpp v23, v41 quad_perm:[1,0,3,2] row_mask:0xf bank_mask:0xf
  v_perm_b32 v40, v22, v40, v18
  v_perm_b32 v41, v23, v41, v18
  v_exp_f32 v66, v50
  v_exp_f32 v67, v51
  global_store_dword v17, v40, s[16:17] offset:-4096 sc1
  v_exp_f32 v70, v54
  v_exp_f32 v71, v55
  v_pk_fma_f32 v[66:67], v[66:67], s[46:47], s[46:47]
  v_pk_fma_f32 v[70:71], v[70:71], s[46:47], s[46:47]
  v_rcp_f32 v66, v66
  v_rcp_f32 v67, v67
  global_store_dword v17, v41, s[16:17] offset:-2048 sc1
  v_rcp_f32 v70, v70
  v_rcp_f32 v71, v71
  v_pk_mul_f32 v[50:51], v[50:51], v[66:67]
  v_pk_mul_f32 v[54:55], v[54:55], v[70:71]
  v_cvt_pk_bf16_f32 v42, v50, v54
  v_cvt_pk_bf16_f32 v43, v51, v55
  v_pk_fma_f32 v[56:57], v[120:121], v[4:5], v[4:5] op_sel:[0,0,1] op_sel_hi:[1,0,1]
  v_pk_fma_f32 v[60:61], v[124:125], v[6:7], v[6:7] op_sel:[0,0,1] op_sel_hi:[1,0,1]
  v_mov_b32_dpp v22, v42 quad_perm:[1,0,3,2] row_mask:0xf bank_mask:0xf
  v_mov_b32_dpp v23, v43 quad_perm:[1,0,3,2] row_mask:0xf bank_mask:0xf
  v_perm_b32 v42, v22, v42, v18
  v_perm_b32 v43, v23, v43, v18
  v_exp_f32 v72, v56
  v_exp_f32 v73, v57
  global_store_dword v17, v42, s[16:17] offset:0 sc1
  v_exp_f32 v76, v60
  v_exp_f32 v77, v61
  v_pk_fma_f32 v[72:73], v[72:73], s[46:47], s[46:47]
  v_pk_fma_f32 v[76:77], v[76:77], s[46:47], s[46:47]
  v_rcp_f32 v72, v72
  v_rcp_f32 v73, v73
  global_store_dword v17, v43, s[16:17] offset:2048 sc1
  v_rcp_f32 v76, v76
  v_rcp_f32 v77, v77
  v_pk_mul_f32 v[56:57], v[56:57], v[72:73]
  v_pk_mul_f32 v[60:61], v[60:61], v[76:77]
  v_cvt_pk_bf16_f32 v44, v56, v60
  v_cvt_pk_bf16_f32 v45, v57, v61
  v_pk_fma_f32 v[58:59], v[122:123], v[4:5], v[4:5] op_sel:[0,0,1] op_sel_hi:[1,0,1]
  v_pk_fma_f32 v[62:63], v[126:127], v[6:7], v[6:7] op_sel:[0,0,1] op_sel_hi:[1,0,1]
  v_mov_b32_dpp v22, v44 quad_perm:[1,0,3,2] row_mask:0xf bank_mask:0xf
  v_mov_b32_dpp v23, v45 quad_perm:[1,0,3,2] row_mask:0xf bank_mask:0xf
  v_perm_b32 v44, v22, v44, v18
  v_perm_b32 v45, v23, v45, v18
  v_exp_f32 v74, v58
  v_exp_f32 v75, v59
  global_store_dword v19, v44, s[16:17] offset:-4096 sc1
  v_exp_f32 v78, v62
  v_exp_f32 v79, v63
  v_pk_fma_f32 v[74:75], v[74:75], s[46:47], s[46:47]
  v_pk_fma_f32 v[78:79], v[78:79], s[46:47], s[46:47]
  v_rcp_f32 v74, v74
  v_rcp_f32 v75, v75
  global_store_dword v19, v45, s[16:17] offset:-2048 sc1
  v_rcp_f32 v78, v78
  v_rcp_f32 v79, v79
  v_pk_mul_f32 v[58:59], v[58:59], v[74:75]
  v_pk_mul_f32 v[62:63], v[62:63], v[78:79]
  v_cvt_pk_bf16_f32 v46, v58, v62
  v_cvt_pk_bf16_f32 v47, v59, v63
  s_nop 0
  v_mov_b32_dpp v22, v46 quad_perm:[1,0,3,2] row_mask:0xf bank_mask:0xf
  v_mov_b32_dpp v23, v47 quad_perm:[1,0,3,2] row_mask:0xf bank_mask:0xf
  v_perm_b32 v46, v22, v46, v18
  v_perm_b32 v47, v23, v47, v18
  global_store_dword v19, v46, s[16:17] offset:0 sc1
  global_store_dword v19, v47, s[16:17] offset:2048 sc1
  s_endpgm
.section .rodata,"a"
.p2align 6
.amdhsa_kernel standalone__batchnorm__sampling_kernel
  .amdhsa_next_free_vgpr 128
  .amdhsa_next_free_sgpr 54
  .amdhsa_accum_offset 128
  .amdhsa_group_segment_fixed_size 0
  .amdhsa_kernarg_size 72
  .amdhsa_user_sgpr_count 2
  .amdhsa_user_sgpr_kernarg_segment_ptr 1
  .amdhsa_system_sgpr_workgroup_id_x 1
  .amdhsa_float_denorm_mode_32 3
.end_amdhsa_kernel
```
